```python
import torch

def _softmax(x, axis=-1):
    return torch.softmax(x, dim=axis)
def _gelu(x):
    return torch.nn.functional.gelu(x, approximate="tanh")
def _silu(x):
    return torch.nn.functional.silu(x)
def _sigmoid(x):
    return torch.sigmoid(x)
def _layernorm(x, axis=-1, eps=1e-5):
    m = x.mean(dim=axis, keepdim=True)
    v = x.var(dim=axis, keepdim=True, unbiased=False)
    return (x - m) / torch.sqrt(v + eps)
def _scatter_add(tgt, idx, src, axis=0):
    return tgt.clone().index_add_(axis, idx, src)
def _segment_sum(src, seg, n):
    out = torch.zeros((n,) + src.shape[1:], dtype=src.dtype)
    return out.index_add_(0, seg, src)
def _pad(x, pw):
    flat = tuple(v for pair in reversed(pw) for v in pair)
    return torch.nn.functional.pad(x, flat)

kernel_name = 'standalone__linear_kernel_rfa__prompt'

def setup_inputs():

    _w = (lambda a: (lambda t: t.to(torch.bfloat16) if t.is_floating_point() else t)(torch.as_tensor(a)))
    B, H, Sq, Sk, D, M = 1, 32, 2048, 2048, 128, 16
    return {
        "q": _w((lambda *s: torch.randn(*s, dtype=torch.bfloat16) * 0.2)(B, H, Sq, D)),
        "k": _w((lambda *s: torch.randn(*s, dtype=torch.bfloat16) * 1.6)(B, H, Sk, D)),
        "v": _w((lambda *s: torch.randn(*s, dtype=torch.bfloat16) * 1.6)(B, H, Sk, D)),
        "omega": _w((lambda *s: torch.randn(*s, dtype=torch.bfloat16) * 1.6)(M, D)),
    }

def reference(q, k, v, omega):
    d = q.shape[-1]
    m = omega.shape[0]
    scale = float(d) ** -0.25
    qs = q * scale
    ks = k * scale
    q_proj = torch.einsum("bhsd,md->bhsm", qs, omega)
    k_proj = torch.einsum("bhsd,md->bhsm", ks, omega)
    q_sq = 0.5 * torch.einsum("bhsd,bhsd->bhs", qs, qs)[..., None]
    k_sq = 0.5 * torch.einsum("bhsd,bhsd->bhs", ks, ks)[..., None]
    inv_sqrt_m = float(m) ** -0.5
    phi_q = torch.exp(q_proj - q_sq) * inv_sqrt_m + 1e-6
    phi_k = torch.exp(k_proj - k_sq) * inv_sqrt_m + 1e-6
    kv = torch.einsum("bhsm,bhsd->bhmd", phi_k, v)
    z  = torch.einsum("bhsm->bhm", phi_k)
    num = torch.einsum("bhqm,bhmd->bhqd", phi_q, kv)
    den = torch.einsum("bhqm,bhm->bhq", phi_q, z)[..., None] + 1e-6
    return num / den
```

```asm
; @launch grid=(256,1,1) block=(576,1,1) lds=147712
.amdgcn_target "amdgcn-amd-amdhsa--gfx950"
.text
.globl standalone__linear_kernel_rfa__prompt_kernel
.p2align 8
.type standalone__linear_kernel_rfa__prompt_kernel,@function
standalone__linear_kernel_rfa__prompt_kernel:
    s_load_dwordx2 s[4:5], s[0:1], 8
    s_load_dwordx2 s[8:9], s[0:1], 24
    s_cmp_ge_u32 s2, 256
    s_cbranch_scc1 L_end
    v_readfirstlane_b32 s33, v0
    v_and_b32 v105, 15, v0
    v_bfe_u32 v106, v0, 4, 2
    s_lshr_b32 s31, s2, 6
    s_and_b32 s32, s2, 7
    s_lshl3_add_u32 s31, s31, s32
    s_bfe_u32 s32, s2, 0x30003
    v_xor_b32 v108, v105, v106
    v_lshlrev_b32 v108, 4, v108
    s_lshl_b32 s28, s31, 19
    s_lshl_b32 s52, s32, 16
    s_add_u32 s28, s28, s52
    s_bfe_u32 s57, s2, 0x40004
    s_lshl_b32 s57, s57, 12
    s_lshr_b32 s33, s33, 6
    s_cbranch_scc1 L_main
    s_setprio 3
    v_lshl_add_u32 v40, v106, 8, v108
    v_xor_b32 v41, 64, v40
    v_xor_b32 v42, 128, v40
    v_xor_b32 v43, 192, v40
    s_mov_b32 s6, 16777216
    s_mov_b32 s7, 0x20000
    s_mov_b32 m0, 65536
    s_add_u32 s52, s28, s57
    s_waitcnt lgkmcnt(0)
    buffer_load_dwordx4 v40, s[4:7], s52 offen offset:0 nt lds
    buffer_load_dwordx4 v41, s[4:7], s52 offen offset:1024 nt lds
    buffer_load_dwordx4 v42, s[4:7], s52 offen offset:2048 nt lds
    buffer_load_dwordx4 v43, s[4:7], s52 offen offset:3072 nt lds
    s_load_dwordx2 s[24:25], s[0:1], 0
    s_load_dwordx2 s[26:27], s[0:1], 16
    s_mov_b32 s10, 4096
    s_mov_b32 s11, 0x20000
    v_lshlrev_b32 v107, 4, v106
    v_lshl_add_u32 v54, v105, 8, v107
    s_mov_b32 m0, 143616
    s_nop 0
    buffer_load_dwordx4 v54, s[8:11], 0 offen offset:0 lds
    s_mov_b32 m0, 144576
    s_mov_b32 s34, 4096
    buffer_load_dwordx4 v54, s[8:11], 0 offen offset:64 lds
    s_mov_b32 m0, 145536
    s_mov_b32 s35, 8192
    buffer_load_dwordx4 v54, s[8:11], 0 offen offset:128 lds
    s_mov_b32 m0, 146496
    s_mov_b32 s36, 65536
    buffer_load_dwordx4 v54, s[8:11], 0 offen offset:192 lds
    s_mov_b32 s37, -5
    s_mov_b32 s38, 0
    v_mov_b32 v52, 0
    v_mov_b32 v1, 143360
    ds_write_b32 v1, v52 offset:8
    v_mov_b32 v44, v40
    v_mov_b32 v45, v41
    v_mov_b32 v46, v42
    v_mov_b32 v47, v43
    v_lshlrev_b32 v109, 1, v106
    v_xor_b32 v109, v109, v105
    v_lshlrev_b32 v109, 4, v109
    v_lshl_add_u32 v48, v106, 8, v109
L_lp0:
    s_add_u32 m0, s36, s34
    s_add_u32 s52, s57, s34
    s_and_b32 s52, s52, 0xffff
    s_add_u32 s52, s28, s52
L_lp:
    s_waitcnt vmcnt(28)
    ds_write_b32 v1, v52
    buffer_load_dwordx4 v40, s[4:7], s52 offen offset:0 nt lds
    buffer_load_dwordx4 v41, s[4:7], s52 offen offset:1024 nt lds
    buffer_load_dwordx4 v42, s[4:7], s52 offen offset:2048 nt lds
    buffer_load_dwordx4 v43, s[4:7], s52 offen offset:3072 nt lds
    s_add_u32 s34, s34, 4096
    s_add_u32 m0, s36, s34
    s_add_u32 s52, s57, s34
    s_and_b32 s52, s52, 0xffff
    s_add_u32 s52, s28, s52
    s_add_u32 s37, s37, 1
    v_mov_b32 v52, s37
    s_cmp_lg_u32 s34, s35
    s_cbranch_scc1 L_lp
    s_add_u32 s38, s38, 1
    s_cmp_eq_u32 s38, 1
    s_cbranch_scc0 L_ph2
    s_waitcnt lgkmcnt(0)
    s_barrier
    s_mov_b32 s35, 65536
    s_branch L_lp
L_ph2:
    s_cmp_eq_u32 s38, 2
    s_cbranch_scc0 L_ph3
    s_mov_b64 s[4:5], s[26:27]
    s_mov_b32 s34, 0
    s_mov_b32 s36, 0
    v_mov_b32 v40, v48
    v_xor_b32 v41, 128, v48
    v_mov_b32 v42, v48
    v_xor_b32 v43, 128, v48
    s_branch L_lp0
L_ph3:
    s_cmp_eq_u32 s38, 3
    s_cbranch_scc0 L_ph4
    s_mov_b64 s[4:5], s[24:25]
    s_mov_b32 s34, 0
    s_mov_b32 s35, 32768
    s_mov_b32 s36, 65536
    v_mov_b32 v40, v44
    v_mov_b32 v41, v45
    v_mov_b32 v42, v46
    v_mov_b32 v43, v47
    s_barrier
    s_branch L_lp0
L_ph4:
    s_add_i32 s37, s37, -2
    s_max_i32 s38, s37, 33
    v_mov_b32 v52, s38
L_lq:
    s_waitcnt vmcnt(36)
    ds_write_b32 v1, v52
    buffer_load_dwordx4 v40, s[4:7], s52 offen offset:0 nt lds
    buffer_load_dwordx4 v41, s[4:7], s52 offen offset:1024 nt lds
    buffer_load_dwordx4 v42, s[4:7], s52 offen offset:2048 nt lds
    buffer_load_dwordx4 v43, s[4:7], s52 offen offset:3072 nt lds
    s_add_u32 s34, s34, 4096
    s_add_u32 m0, s36, s34
    s_add_u32 s52, s57, s34
    s_and_b32 s52, s52, 0xffff
    s_add_u32 s52, s28, s52
    s_add_u32 s37, s37, 1
    s_max_i32 s38, s37, 33
    v_mov_b32 v52, s38
    s_cmp_lg_u32 s34, 65536
    s_cbranch_scc1 L_lq
    v_mov_b32 v53, 40
    s_waitcnt vmcnt(36)
    ds_write_b32 v1, v53
    v_mov_b32 v52, 41
    s_waitcnt vmcnt(32)
    ds_write_b32 v1, v52
    v_mov_b32 v53, 42
    s_waitcnt vmcnt(28)
    ds_write_b32 v1, v53
    v_mov_b32 v52, 43
    s_waitcnt vmcnt(24)
    ds_write_b32 v1, v52
    v_mov_b32 v53, 44
    s_waitcnt vmcnt(20)
    ds_write_b32 v1, v53
    v_mov_b32 v52, 45
    s_waitcnt vmcnt(16)
    ds_write_b32 v1, v52
    v_mov_b32 v53, 46
    s_waitcnt vmcnt(12)
    ds_write_b32 v1, v53
    v_mov_b32 v52, 47
    s_waitcnt vmcnt(8)
    ds_write_b32 v1, v52
    v_mov_b32 v53, 48
    s_waitcnt vmcnt(4)
    ds_write_b32 v1, v53
    v_mov_b32 v52, 49
    s_waitcnt vmcnt(0)
    ds_write_b32 v1, v52
    s_endpgm
L_main:
    s_load_dwordx2 s[12:13], s[0:1], 32
    s_load_dwordx2 s[20:21], s[0:1], 40
    s_load_dwordx2 s[16:17], s[0:1], 48
    s_memrealtime s[24:25]
    s_getpc_b64 s[60:61]
L_pc:
    s_cmp_lg_u32 s33, 1
    s_cbranch_scc1 L_nopf
    v_and_b32 v109, 63, v0
    v_lshlrev_b32 v109, 7, v109
    v_min_u32 v109, L_codeend-L_pc-4, v109
    global_load_dword v164, v109, s[60:61]
L_nopf:
    s_barrier
    v_mov_b32 v1, 143360
    v_lshlrev_b32 v166, 4, v106
    v_and_b32 v5, 63, v0
    v_lshlrev_b32 v5, 4, v5
    s_mul_i32 s49, s31, 69632
    v_add_u32 v7, 131072, v5
    s_mov_b32 s53, 3200000
    s_mov_b32 s55, 200000
    s_mov_b32 s18, 4194304
    s_mov_b32 s19, 0x20000
    s_mov_b32 s22, 256
    s_mov_b32 s23, 0x20000
    s_mov_b32 s14, 16777216
    s_mov_b32 s15, 0x20000
    s_add_u32 s62, s60, L_phiq-L_pc
    s_addc_u32 s63, s61, 0
    s_add_u32 s60, s60, L_phik-L_pc
    s_addc_u32 s61, s61, 0
    s_sub_u32 s30, s33, 1
    s_lshl_b32 s54, s30, 12
    s_add_u32 s52, s54, s57
    s_and_b32 s52, s52, 0xffff
    s_xor_b32 s29, s52, 0x8000
    s_add_u32 s29, s28, s29
    s_add_u32 s28, s28, s52
    s_add_u32 s52, s54, 65536
    s_lshl_b32 s54, s30, 13
    v_lshl_add_u32 v108, v105, 8, v108
    v_add_u32 v160, s52, v108
    v_xor_b32 v161, 64, v160
    v_xor_b32 v162, 128, v160
    v_xor_b32 v163, 192, v160
    s_add_u32 s26, s49, 67584
    s_lshl_b32 s52, s30, 8
    s_add_u32 s50, s49, s52
    s_add_u32 s50, s50, 65536
    s_add_u32 s49, s49, s54
    s_add_u32 s64, s32, 1
    s_and_b32 s64, s64, 7
    s_lshl_b32 s64, s64, 10
    s_add_u32 s64, s64, s49
    s_add_u32 s65, s32, 2
    s_and_b32 s65, s65, 7
    s_lshl_b32 s65, s65, 10
    s_add_u32 s65, s65, s49
    s_add_u32 s66, s32, 3
    s_and_b32 s66, s66, 7
    s_lshl_b32 s66, s66, 10
    s_add_u32 s66, s66, s49
    s_add_u32 s67, s32, 4
    s_and_b32 s67, s67, 7
    s_lshl_b32 s67, s67, 10
    s_add_u32 s67, s67, s49
    s_add_u32 s68, s32, 5
    s_and_b32 s68, s68, 7
    s_lshl_b32 s68, s68, 10
    s_add_u32 s68, s68, s49
    s_add_u32 s69, s32, 6
    s_and_b32 s69, s69, 7
    s_lshl_b32 s69, s69, 10
    s_add_u32 s69, s69, s49
    s_add_u32 s70, s32, 7
    s_and_b32 s70, s70, 7
    s_lshl_b32 s70, s70, 10
    s_add_u32 s70, s70, s49
    s_mov_b32 s34, 0x3e9837f0
    s_mov_b32 s35, 0x3e9837f0
    s_mov_b32 s36, 0x3fb8aa3b
    s_mov_b32 s37, 0x3fb8aa3b
    s_mov_b32 s38, 0x3e800000
    s_mov_b32 s39, 0x3e800000
    s_mov_b32 s40, 0x100001
    s_mov_b32 s41, 0x10000100
    s_mov_b32 s42, 0x200002
    s_mov_b32 s43, 0x20000200
    s_mov_b32 s44, 0x400004
    s_mov_b32 s45, 0x40000400
    s_mov_b32 s46, 0x800008
    s_mov_b32 s47, 0x80000800
    s_mov_b32 s48, 0x9E3779B1
    v_mov_b32 v18, 0x35860000
    v_mov_b32 v19, 0x35860000
    v_mov_b32 v20, 0xbf00bf00
    v_mov_b32 v21, 0xbf00bf00
    v_mov_b32 v23, 0
    s_lshl_b32 s52, s30, 10
    v_add_u32 v15, s52, v7
    v_lshrrev_b32 v108, 2, v105
    v_lshl_add_u32 v108, v106, 2, v108
    v_and_b32 v109, 7, v108
    v_xor_b32 v109, s30, v109
    v_lshlrev_b32 v109, 5, v109
    v_lshl_add_u32 v109, v108, 8, v109
    v_and_b32 v111, 3, v105
    v_lshl_add_u32 v6, v111, 3, v109
    s_lshr_b32 s52, s30, 1
    v_bfe_u32 v108, v105, 1, 2
    v_xor_b32 v108, s52, v108
    v_lshlrev_b32 v108, 4, v108
    v_and_b32 v109, 1, v105
    v_lshl_add_u32 v108, v109, 3, v108
    v_lshrrev_b32 v109, 3, v105
    v_lshl_add_u32 v108, v109, 6, v108
    v_lshl_add_u32 v108, v106, 10, v108
    s_lshl_b32 s52, s30, 7
    s_add_u32 s52, s52, 139264
    v_add_u32 v8, s52, v108
    v_lshrrev_b32 v108, 2, v105
    v_lshlrev_b32 v108, 4, v108
    v_lshl_add_u32 v108, v105, 6, v108
    v_lshl_add_u32 v108, v106, 10, v108
    v_add_u32 v10, 139264, v108
    v_xor_b32 v11, 16, v10
    v_xor_b32 v12, 32, v10
    v_xor_b32 v13, 48, v10
    v_lshrrev_b32 v0, 5, v5
    v_and_b32 v0, 28, v0
    v_lshlrev_b32 v108, 4, v105
    v_lshl_add_u32 v14, v106, 10, v108
    v_and_b32 v4, 7, v105
    v_lshl_add_u32 v9, v4, 7, v166
    v_lshlrev_b32 v108, 2, v106
    v_lshl_add_u32 v165, v4, 7, v108
    v_lshl_add_u32 v167, v106, 3, v1
    s_waitcnt lgkmcnt(0)
    s_lshl_b32 s52, s2, 3
    s_add_u32 s52, s52, s30
    s_and_b32 s52, s52, 0xffffffc7
    s_cbranch_scc1 L_noroot
    s_or_b32 s24, s24, 0x80000000
    v_mov_b32 v22, s24
    s_mov_b64 exec, 1
    buffer_atomic_cmpswap v[22:23], off, s[20:23], 0 sc1
    s_mov_b64 exec, -1
L_noroot:
    s_add_u32 s56, s30, 2
L_p0:
    ds_read_b32 v104, v1
    s_sub_u32 s53, s53, 1
    s_waitcnt lgkmcnt(0)
    v_cmp_le_i32 vcc, s56, v104
    s_cbranch_vccnz L_pk0
    s_sleep 1
    s_cbranch_scc0 L_p0
    s_mov_b32 s53, 0
L_pk0:
    ds_read_b128 v[24:27], v7 offset:12544
    ds_read_b128 v[28:31], v7 offset:13568
    ds_read_b128 v[32:35], v7 offset:14592
    ds_read_b128 v[36:39], v7 offset:15616
    ds_read_b128 v[72:75], v160 offset:0
    ds_read_b128 v[76:79], v161 offset:0
    ds_read_b128 v[80:83], v162 offset:0
    ds_read_b128 v[84:87], v163 offset:0
    s_swappc_b64 s[58:59], s[60:61]
    v_mov_b32 v40, v16
    v_mov_b32 v41, v17
    s_cmp_lg_u32 s30, 4
    s_cbranch_scc1 L_nn1
    buffer_load_dword v100, off, s[20:23], 0 sc1
L_nn1:
    s_add_u32 s56, s30, 10
L_p1:
    ds_read_b32 v104, v1
    s_sub_u32 s53, s53, 1
    s_waitcnt lgkmcnt(0)
    v_cmp_le_i32 vcc, s56, v104
    s_cbranch_vccnz L_pk1
    s_sleep 1
    s_cbranch_scc0 L_p1
    s_mov_b32 s53, 0
L_pk1:
    ds_read_b128 v[72:75], v160 offset:32768
    ds_read_b128 v[76:79], v161 offset:32768
    ds_read_b128 v[80:83], v162 offset:32768
    ds_read_b128 v[84:87], v163 offset:32768
    s_swappc_b64 s[58:59], s[60:61]
    ds_write2_b64 v15, v[40:41], v[16:17] offset0:0 offset1:1
    s_cmp_lg_u32 s30, 4
    s_cbranch_scc1 L_nn2
L_non:
    s_sub_u32 s55, s55, 1
    s_waitcnt vmcnt(0)
    v_cmp_ne_u32 vcc, 0, v100
    s_cbranch_vccnz L_nonk
    buffer_load_dword v100, off, s[20:23], 0 sc1
    s_cbranch_scc0 L_non
    s_mov_b32 s55, 0
    s_waitcnt vmcnt(0)
L_nonk:
    ds_write_b32 v1, v100 offset:4
L_nn2:
    s_waitcnt lgkmcnt(0)
    s_barrier
    ds_read_b32 v100, v1 offset:4
    ds_read_b128 v[40:43], v7 offset:0
    ds_read_b128 v[44:47], v7 offset:1024
    ds_read_b128 v[48:51], v7 offset:2048
    ds_read_b128 v[52:55], v7 offset:3072
    ds_read_b128 v[56:59], v7 offset:4096
    ds_read_b128 v[60:63], v7 offset:5120
    ds_read_b128 v[64:67], v7 offset:6144
    ds_read_b128 v[68:71], v7 offset:7168
    s_waitcnt lgkmcnt(8)
    v_add_u32 v4, v4, v100
    v_mul_lo_u32 v4, v4, s48
    v_lshrrev_b32 v104, 15, v4
    v_xor_b32 v4, v4, v104
    v_mul_lo_u32 v4, v4, s48
    v_lshrrev_b32 v104, 13, v4
    v_xor_b32 v4, v4, v104
    v_mov_b32 v101, v4
    v_readlane_b32 s52, v4, s32
    s_nop 1
    v_add_u32_dpp v101, v101, v101 quad_perm:[1,0,3,2] row_mask:0xf bank_mask:0xf
    s_nop 1
    v_add_u32_dpp v101, v101, v101 quad_perm:[2,3,0,1] row_mask:0xf bank_mask:0xf
    s_nop 1
    v_add_u32_dpp v101, v101, v101 row_half_mirror row_mask:0xf bank_mask:0xf
    v_mov_b32 v100, s52
    v_sub_u32 v101, v101, v100
    s_cmp_lg_u32 s30, 0
    s_cbranch_scc1 L_nz
    v_mov_b32 v116, 0x3f803f80
    v_mov_b32 v117, v116
    v_mov_b32 v118, v116
    v_mov_b32 v119, v116
    s_lshl_b32 s52, s32, 7
    s_add_u32 s52, s52, s26
    s_waitcnt lgkmcnt(0)
    v_mfma_f32_16x16x32_bf16 v[120:123], v[40:43], v[116:119], 0
    v_mfma_f32_16x16x32_bf16 v[120:123], v[44:47], v[116:119], v[120:123]
    v_mfma_f32_16x16x32_bf16 v[120:123], v[48:51], v[116:119], v[120:123]
    v_mfma_f32_16x16x32_bf16 v[120:123], v[52:55], v[116:119], v[120:123]
    v_mfma_f32_16x16x32_bf16 v[120:123], v[56:59], v[116:119], v[120:123]
    v_mfma_f32_16x16x32_bf16 v[120:123], v[60:63], v[116:119], v[120:123]
    v_mfma_f32_16x16x32_bf16 v[120:123], v[64:67], v[116:119], v[120:123]
    v_mfma_f32_16x16x32_bf16 v[120:123], v[68:71], v[116:119], v[120:123]
    v_lshrrev_b32 v105, 2, v166
    s_mov_b32 exec_lo, 0x00010001
    s_mov_b32 exec_hi, 0x00010001
    s_nop 4
    buffer_store_dwordx4 v[120:123], v166, s[16:19], s52 offen sc1
    v_add3_u32 v104, v120, v121, v122
    v_add_u32 v104, v104, v123
    v_sub_u32 v104, v100, v104
    buffer_store_dword v104, v105, s[16:19], s52 offen offset:64 sc1
    s_mov_b64 exec, -1
L_nz:
    s_lshl_b32 s52, s32, 10
    s_add_u32 s52, s52, s49
    s_lshl_b32 s51, s32, 5
    s_add_u32 s51, s51, s50
L_p2:
    ds_read_b32 v104, v1
    s_sub_u32 s53, s53, 1
    s_waitcnt lgkmcnt(0)
    v_cmp_le_i32 vcc, 30, v104
    s_cbranch_vccnz L_pk2
    s_sleep 1
    s_cbranch_scc0 L_p2
    s_mov_b32 s53, 0
L_pk2:
    ds_read_b64_tr_b16 v[128:129], v6 offset:0
    ds_read_b64_tr_b16 v[130:131], v6 offset:32768
    ds_read_b64_tr_b16 v[132:133], v6 offset:4096
    ds_read_b64_tr_b16 v[134:135], v6 offset:36864
    ds_read_b64_tr_b16 v[136:137], v6 offset:8192
    ds_read_b64_tr_b16 v[138:139], v6 offset:40960
    ds_read_b64_tr_b16 v[140:141], v6 offset:12288
    ds_read_b64_tr_b16 v[142:143], v6 offset:45056
    ds_read_b64_tr_b16 v[144:145], v6 offset:16384
    ds_read_b64_tr_b16 v[146:147], v6 offset:49152
    s_waitcnt lgkmcnt(8)
    v_mfma_f32_16x16x32_bf16 v[96:99], v[40:43], v[128:131], 0
    s_waitcnt lgkmcnt(6)
    v_mfma_f32_16x16x32_bf16 v[96:99], v[44:47], v[132:135], v[96:99]
    s_waitcnt lgkmcnt(4)
    v_mfma_f32_16x16x32_bf16 v[96:99], v[48:51], v[136:139], v[96:99]
    s_waitcnt lgkmcnt(2)
    v_mfma_f32_16x16x32_bf16 v[96:99], v[52:55], v[140:143], v[96:99]
    s_waitcnt lgkmcnt(0)
    v_mfma_f32_16x16x32_bf16 v[96:99], v[56:59], v[144:147], v[96:99]
L_p3:
    ds_read_b32 v104, v1
    s_sub_u32 s53, s53, 1
    s_waitcnt lgkmcnt(0)
    v_cmp_le_i32 vcc, 33, v104
    s_cbranch_vccnz L_pk3
    s_cbranch_scc0 L_p3
    s_mov_b32 s53, 0
L_pk3:
    ds_read_b64_tr_b16 v[148:149], v6 offset:20480
    ds_read_b64_tr_b16 v[150:151], v6 offset:53248
    ds_read_b64_tr_b16 v[152:153], v6 offset:24576
    ds_read_b64_tr_b16 v[154:155], v6 offset:57344
    ds_read_b64_tr_b16 v[156:157], v6 offset:28672
    ds_read_b64_tr_b16 v[158:159], v6 offset:61440
    s_waitcnt lgkmcnt(4)
    v_mfma_f32_16x16x32_bf16 v[96:99], v[60:63], v[148:151], v[96:99]
    s_waitcnt lgkmcnt(2)
    v_mfma_f32_16x16x32_bf16 v[96:99], v[64:67], v[152:155], v[96:99]
    s_waitcnt lgkmcnt(0)
    v_mfma_f32_16x16x32_bf16 v[96:99], v[68:71], v[156:159], v[96:99]
    v_and_b32 v157, 0x70, v5
    s_lshl_b32 s56, s32, 4
    v_cmp_eq_u32 vcc, s56, v157
    v_lshl_add_u32 v157, v157, 1, v0
    s_nop 0
    v_cndmask_b32 v157, v157, v20, vcc
    s_nop 1
    buffer_store_dwordx4 v[96:99], v5, s[16:19], s52 offen sc1
    v_add_u32 v104, v96, v97
    v_add3_u32 v104, v104, v98, v99
    s_nop 1
    v_add_u32_dpp v104, v104, v104 quad_perm:[1,0,3,2] row_mask:0xf bank_mask:0xf
    s_nop 1
    v_add_u32_dpp v104, v104, v104 quad_perm:[2,3,0,1] row_mask:0xf bank_mask:0xf
    s_nop 1
    v_add_u32_dpp v104, v104, v104 row_half_mirror row_mask:0xf bank_mask:0xf
    v_sub_u32 v104, v100, v104
    s_mov_b32 exec_lo, 0x01010101
    s_mov_b32 exec_hi, 0x01010101
    buffer_store_dword v104, v0, s[16:19], s51 offen sc1
    s_mov_b64 exec, -1
    s_add_u32 s56, s30, 34
L_p4:
    ds_read_b32 v104, v1
    s_sub_u32 s53, s53, 1
    s_waitcnt lgkmcnt(0)
    v_cmp_le_i32 vcc, s56, v104
    s_cbranch_vccnz L_pk4
    s_sleep 1
    s_cbranch_scc0 L_p4
    s_mov_b32 s53, 0
L_pk4:
    ds_read_b128 v[72:75], v160 offset:0
    ds_read_b128 v[76:79], v161 offset:0
    ds_read_b128 v[80:83], v162 offset:0
    ds_read_b128 v[84:87], v163 offset:0
    s_swappc_b64 s[58:59], s[62:63]
    v_mov_b32 v2, v16
    v_mov_b32 v3, v17
    s_cmp_lg_u32 s30, 0
    s_cbranch_scc1 L_nzl
    buffer_load_dwordx4 v[92:95], v9, s[16:19], s26 offen sc1
    buffer_load_dword v91, v165, s[16:19], s26 offen offset:64 sc1
L_nzl:
    s_mov_b32 s57, 0
    s_cmp_ge_u32 s30, 4
    s_cbranch_scc1 L_nb
    s_add_u32 s56, s30, 42
L_p5:
    ds_read_b32 v104, v1
    s_sub_u32 s53, s53, 1
    s_waitcnt lgkmcnt(0)
    v_cmp_le_i32 vcc, s56, v104
    s_cbranch_vccnz L_pk5
    s_cbranch_scc0 L_p5
    s_mov_b32 s53, 0
L_pk5:
    ds_read_b128 v[72:75], v160 offset:32768
    ds_read_b128 v[76:79], v161 offset:32768
    ds_read_b128 v[80:83], v162 offset:32768
    ds_read_b128 v[84:87], v163 offset:32768
    s_swappc_b64 s[58:59], s[62:63]
    s_mov_b32 s57, 1
L_nb:
    s_cmp_lg_u32 s30, 0
    s_cbranch_scc1 L_nzr
    s_waitcnt vmcnt(0)
L_zchk:
    v_add3_u32 v91, v91, v92, v93
    v_add_f32_dpp v104, v92, v92 quad_perm:[1,0,3,2] row_mask:0xf bank_mask:0xf
    v_add_f32_dpp v105, v93, v93 quad_perm:[1,0,3,2] row_mask:0xf bank_mask:0xf
    v_add_f32_dpp v106, v94, v94 quad_perm:[1,0,3,2] row_mask:0xf bank_mask:0xf
    v_add_f32_dpp v107, v95, v95 quad_perm:[1,0,3,2] row_mask:0xf bank_mask:0xf
    v_add3_u32 v91, v91, v94, v95
    v_add_f32_dpp v108, v104, v104 quad_perm:[2,3,0,1] row_mask:0xf bank_mask:0xf
    v_add_f32_dpp v109, v105, v105 quad_perm:[2,3,0,1] row_mask:0xf bank_mask:0xf
    v_add_f32_dpp v110, v106, v106 quad_perm:[2,3,0,1] row_mask:0xf bank_mask:0xf
    v_add_f32_dpp v111, v107, v107 quad_perm:[2,3,0,1] row_mask:0xf bank_mask:0xf
    v_cmp_ne_u32 vcc, v91, v4
    v_add_f32_dpp v104, v108, v108 row_half_mirror row_mask:0xf bank_mask:0xf
    v_add_f32_dpp v105, v109, v109 row_half_mirror row_mask:0xf bank_mask:0xf
    v_add_f32_dpp v106, v110, v110 row_half_mirror row_mask:0xf bank_mask:0xf
    v_add_f32_dpp v107, v111, v111 row_half_mirror row_mask:0xf bank_mask:0xf
    s_cbranch_vccnz L_zbad
L_zok:
    v_cvt_pk_bf16_f32 v144, v104, v105
    v_cvt_pk_bf16_f32 v145, v106, v107
    v_mov_b32 v108, 1
    ds_write_b64 v167, v[144:145] offset:32
    ds_write_b32 v1, v108 offset:8
L_nzr:
L_p6:
    ds_read_b32 v104, v1
    s_sub_u32 s53, s53, 1
    s_waitcnt lgkmcnt(0)
    v_cmp_le_i32 vcc, 45, v104
    s_cbranch_vccnz L_pk6
    s_cbranch_scc0 L_p6
    s_mov_b32 s53, 0
L_pk6:
    buffer_load_dwordx4 v[44:47], v5, s[16:19], s64 offen
    buffer_load_dwordx4 v[48:51], v5, s[16:19], s65 offen
    buffer_load_dwordx4 v[52:55], v5, s[16:19], s66 offen
    buffer_load_dwordx4 v[56:59], v5, s[16:19], s67 offen
    buffer_load_dwordx4 v[60:63], v5, s[16:19], s68 offen
    buffer_load_dwordx4 v[64:67], v5, s[16:19], s69 offen
    buffer_load_dwordx4 v[68:71], v5, s[16:19], s70 offen
    buffer_load_dword v88, v157, s[16:19], s50 offen
L_pz:
    ds_read_b32 v104, v1 offset:8
    ds_read_b64 v[144:145], v167 offset:32
    s_sub_u32 s53, s53, 1
    s_waitcnt lgkmcnt(0)
    v_cmp_le_i32 vcc, 1, v104
    s_cbranch_vccnz L_pzk
    s_cbranch_scc0 L_pz
    s_mov_b32 s53, 0
L_pzk:
    v_mfma_f32_16x16x16_bf16 v[148:151], v[2:3], v[144:145], 0
    s_cmp_eq_u32 s57, 0
    s_cbranch_scc1 L_nob
    v_mfma_f32_16x16x16_bf16 v[152:155], v[16:17], v[144:145], 0
    s_nop 7
    v_cvt_pk_bf16_f32 v152, 0, v152
    v_cvt_pk_bf16_f32 v153, 0, v153
    v_cvt_pk_bf16_f32 v154, 0, v154
    v_cvt_pk_bf16_f32 v155, 0, v155
    v_pk_add_f32 v[152:153], v[152:153], v[18:19]
    v_pk_add_f32 v[154:155], v[154:155], v[18:19]
    v_cvt_pk_bf16_f32 v152, 0, v152
    v_cvt_pk_bf16_f32 v153, 0, v153
    v_cvt_pk_bf16_f32 v154, 0, v154
    v_cvt_pk_bf16_f32 v155, 0, v155
    v_rcp_f32 v152, v152
    v_rcp_f32 v153, v153
    v_rcp_f32 v154, v154
    v_rcp_f32 v155, v155
L_nob:
    s_nop 5
    v_cvt_pk_bf16_f32 v148, 0, v148
    v_cvt_pk_bf16_f32 v149, 0, v149
    v_cvt_pk_bf16_f32 v150, 0, v150
    v_cvt_pk_bf16_f32 v151, 0, v151
    v_pk_add_f32 v[148:149], v[148:149], v[18:19]
    v_pk_add_f32 v[150:151], v[150:151], v[18:19]
    v_cvt_pk_bf16_f32 v148, 0, v148
    v_cvt_pk_bf16_f32 v149, 0, v149
    v_cvt_pk_bf16_f32 v150, 0, v150
    v_cvt_pk_bf16_f32 v151, 0, v151
    v_rcp_f32 v148, v148
    v_rcp_f32 v149, v149
    v_rcp_f32 v150, v150
    v_rcp_f32 v151, v151
L_gsum:
    s_waitcnt vmcnt(7)
    v_pk_add_f32 v[104:105], v[96:97], v[44:45]
    v_pk_add_f32 v[106:107], v[98:99], v[46:47]
    v_add_u32 v90, v44, v45
    v_add_u32 v89, v46, v47
    s_waitcnt vmcnt(6)
    v_pk_add_f32 v[104:105], v[104:105], v[48:49]
    v_pk_add_f32 v[106:107], v[106:107], v[50:51]
    v_add3_u32 v90, v90, v48, v49
    v_add3_u32 v89, v89, v50, v51
    s_waitcnt vmcnt(5)
    v_pk_add_f32 v[104:105], v[104:105], v[52:53]
    v_pk_add_f32 v[106:107], v[106:107], v[54:55]
    v_add3_u32 v90, v90, v52, v53
    v_add3_u32 v89, v89, v54, v55
    s_waitcnt vmcnt(4)
    v_pk_add_f32 v[104:105], v[104:105], v[56:57]
    v_pk_add_f32 v[106:107], v[106:107], v[58:59]
    v_add3_u32 v90, v90, v56, v57
    v_add3_u32 v89, v89, v58, v59
    s_waitcnt vmcnt(3)
    v_pk_add_f32 v[104:105], v[104:105], v[60:61]
    v_pk_add_f32 v[106:107], v[106:107], v[62:63]
    v_add3_u32 v90, v90, v60, v61
    v_add3_u32 v89, v89, v62, v63
    s_waitcnt vmcnt(2)
    v_pk_add_f32 v[104:105], v[104:105], v[64:65]
    v_pk_add_f32 v[106:107], v[106:107], v[66:67]
    v_add3_u32 v90, v90, v64, v65
    v_add3_u32 v89, v89, v66, v67
    s_waitcnt vmcnt(0)
    v_pk_add_f32 v[104:105], v[104:105], v[68:69]
    v_pk_add_f32 v[106:107], v[106:107], v[70:71]
    v_add3_u32 v90, v90, v68, v69
    v_add3_u32 v89, v89, v70, v71
    v_add3_u32 v88, v88, v89, v90
    v_cvt_pk_bf16_f32 v116, v104, v105
    v_cvt_pk_bf16_f32 v117, v106, v107
    v_add_u32_dpp v88, v88, v88 quad_perm:[1,0,3,2] row_mask:0xf bank_mask:0xf
    ds_write_b64 v8, v[116:117]
    s_sub_u32 s55, s55, 1
    v_add_u32_dpp v88, v88, v88 quad_perm:[2,3,0,1] row_mask:0xf bank_mask:0xf
    s_nop 1
    v_add_u32_dpp v88, v88, v88 row_half_mirror row_mask:0xf bank_mask:0xf
    v_cmp_ne_u32 vcc, v88, v101
    s_cbranch_vccnz L_regather
L_gok:
    s_waitcnt lgkmcnt(0)
    s_barrier
    ds_read_b128 v[128:131], v10
    ds_read_b128 v[132:135], v11
    ds_read_b128 v[136:139], v12
    ds_read_b128 v[140:143], v13
    ds_read_b128 v[72:75], v160 offset:32768
    ds_read_b128 v[76:79], v161 offset:32768
    ds_read_b128 v[80:83], v162 offset:32768
    ds_read_b128 v[84:87], v163 offset:32768
    s_waitcnt lgkmcnt(7)
    v_mfma_f32_16x16x16_bf16 v[40:43], v[2:3], v[128:129], 0
    v_mfma_f32_16x16x16_bf16 v[44:47], v[2:3], v[130:131], 0
    s_waitcnt lgkmcnt(6)
    v_mfma_f32_16x16x16_bf16 v[48:51], v[2:3], v[132:133], 0
    v_mfma_f32_16x16x16_bf16 v[52:55], v[2:3], v[134:135], 0
    s_waitcnt lgkmcnt(5)
    v_mfma_f32_16x16x16_bf16 v[56:59], v[2:3], v[136:137], 0
    v_mfma_f32_16x16x16_bf16 v[60:63], v[2:3], v[138:139], 0
    s_waitcnt lgkmcnt(4)
    v_cvt_pk_bf16_f32 v40, 0, v40
    v_cvt_pk_bf16_f32 v41, 0, v41
    v_mfma_f32_16x16x16_bf16 v[64:67], v[2:3], v[140:141], 0
    v_cvt_pk_bf16_f32 v44, 0, v44
    v_cvt_pk_bf16_f32 v45, 0, v45
    v_mfma_f32_16x16x16_bf16 v[68:71], v[2:3], v[142:143], 0
    v_cvt_pk_bf16_f32 v48, 0, v48
    v_cvt_pk_bf16_f32 v49, 0, v49
    v_cvt_pk_bf16_f32 v52, 0, v52
    v_cvt_pk_bf16_f32 v53, 0, v53
    v_cvt_pk_bf16_f32 v56, 0, v56
    v_cvt_pk_bf16_f32 v57, 0, v57
    v_cvt_pk_bf16_f32 v60, 0, v60
    v_cvt_pk_bf16_f32 v61, 0, v61
    v_cvt_pk_bf16_f32 v64, 0, v64
    v_cvt_pk_bf16_f32 v65, 0, v65
    v_cvt_pk_bf16_f32 v68, 0, v68
    v_cvt_pk_bf16_f32 v69, 0, v69
    v_pk_mul_f32 v[40:41], v[40:41], v[148:149]
    v_pk_mul_f32 v[44:45], v[44:45], v[148:149]
    v_pk_mul_f32 v[48:49], v[48:49], v[148:149]
    v_pk_mul_f32 v[52:53], v[52:53], v[148:149]
    v_pk_mul_f32 v[56:57], v[56:57], v[148:149]
    v_pk_mul_f32 v[60:61], v[60:61], v[148:149]
    v_pk_mul_f32 v[64:65], v[64:65], v[148:149]
    v_pk_mul_f32 v[68:69], v[68:69], v[148:149]
    v_cvt_pk_bf16_f32 v104, v40, v44
    v_cvt_pk_bf16_f32 v105, v48, v52
    v_cvt_pk_bf16_f32 v106, v56, v60
    v_cvt_pk_bf16_f32 v107, v64, v68
    buffer_store_dwordx4 v[104:107], v14, s[12:15], s28 offen offset:0 nt
    v_cvt_pk_bf16_f32 v108, v41, v45
    v_cvt_pk_bf16_f32 v109, v49, v53
    v_cvt_pk_bf16_f32 v110, v57, v61
    v_cvt_pk_bf16_f32 v111, v65, v69
    buffer_store_dwordx4 v[108:111], v14, s[12:15], s28 offen offset:256 nt
    v_cvt_pk_bf16_f32 v42, 0, v42
    v_cvt_pk_bf16_f32 v43, 0, v43
    v_cvt_pk_bf16_f32 v46, 0, v46
    v_cvt_pk_bf16_f32 v47, 0, v47
    v_cvt_pk_bf16_f32 v50, 0, v50
    v_cvt_pk_bf16_f32 v51, 0, v51
    v_cvt_pk_bf16_f32 v54, 0, v54
    v_cvt_pk_bf16_f32 v55, 0, v55
    v_cvt_pk_bf16_f32 v58, 0, v58
    v_cvt_pk_bf16_f32 v59, 0, v59
    v_cvt_pk_bf16_f32 v62, 0, v62
    v_cvt_pk_bf16_f32 v63, 0, v63
    v_cvt_pk_bf16_f32 v66, 0, v66
    v_cvt_pk_bf16_f32 v67, 0, v67
    v_cvt_pk_bf16_f32 v70, 0, v70
    v_cvt_pk_bf16_f32 v71, 0, v71
    v_pk_mul_f32 v[42:43], v[42:43], v[150:151]
    v_pk_mul_f32 v[46:47], v[46:47], v[150:151]
    v_pk_mul_f32 v[50:51], v[50:51], v[150:151]
    v_pk_mul_f32 v[54:55], v[54:55], v[150:151]
    v_pk_mul_f32 v[58:59], v[58:59], v[150:151]
    v_pk_mul_f32 v[62:63], v[62:63], v[150:151]
    v_pk_mul_f32 v[66:67], v[66:67], v[150:151]
    v_pk_mul_f32 v[70:71], v[70:71], v[150:151]
    v_cvt_pk_bf16_f32 v112, v42, v46
    v_cvt_pk_bf16_f32 v113, v50, v54
    v_cvt_pk_bf16_f32 v114, v58, v62
    v_cvt_pk_bf16_f32 v115, v66, v70
    buffer_store_dwordx4 v[112:115], v14, s[12:15], s28 offen offset:512 nt
    v_cvt_pk_bf16_f32 v116, v43, v47
    v_cvt_pk_bf16_f32 v117, v51, v55
    v_cvt_pk_bf16_f32 v118, v59, v63
    v_cvt_pk_bf16_f32 v119, v67, v71
    buffer_store_dwordx4 v[116:119], v14, s[12:15], s28 offen offset:768 nt
    s_cmp_lg_u32 s57, 0
    s_cbranch_scc1 L_j2
    s_swappc_b64 s[58:59], s[62:63]
    s_nop 0
    v_mfma_f32_16x16x16_bf16 v[152:155], v[16:17], v[144:145], 0
    v_mfma_f32_16x16x16_bf16 v[72:75], v[16:17], v[128:129], 0
    v_mfma_f32_16x16x16_bf16 v[76:79], v[16:17], v[130:131], 0
    v_mfma_f32_16x16x16_bf16 v[80:83], v[16:17], v[132:133], 0
    v_mfma_f32_16x16x16_bf16 v[84:87], v[16:17], v[134:135], 0
    s_nop 3
    v_cvt_pk_bf16_f32 v152, 0, v152
    v_cvt_pk_bf16_f32 v153, 0, v153
    v_cvt_pk_bf16_f32 v154, 0, v154
    v_cvt_pk_bf16_f32 v155, 0, v155
    v_mfma_f32_16x16x16_bf16 v[88:91], v[16:17], v[136:137], 0
    v_pk_add_f32 v[152:153], v[152:153], v[18:19]
    v_pk_add_f32 v[154:155], v[154:155], v[18:19]
    v_cvt_pk_bf16_f32 v152, 0, v152
    v_mfma_f32_16x16x16_bf16 v[92:95], v[16:17], v[138:139], 0
    v_cvt_pk_bf16_f32 v153, 0, v153
    v_cvt_pk_bf16_f32 v154, 0, v154
    v_cvt_pk_bf16_f32 v155, 0, v155
    v_mfma_f32_16x16x16_bf16 v[96:99], v[16:17], v[140:141], 0
    v_rcp_f32 v152, v152
    v_rcp_f32 v153, v153
    v_mfma_f32_16x16x16_bf16 v[100:103], v[16:17], v[142:143], 0
    v_rcp_f32 v154, v154
    v_rcp_f32 v155, v155
    s_branch L_j3
L_j2:
    s_waitcnt lgkmcnt(0)
    v_mfma_f32_16x16x16_bf16 v[72:75], v[16:17], v[128:129], 0
    v_mfma_f32_16x16x16_bf16 v[76:79], v[16:17], v[130:131], 0
    v_mfma_f32_16x16x16_bf16 v[80:83], v[16:17], v[132:133], 0
    v_mfma_f32_16x16x16_bf16 v[84:87], v[16:17], v[134:135], 0
    v_mfma_f32_16x16x16_bf16 v[88:91], v[16:17], v[136:137], 0
    v_mfma_f32_16x16x16_bf16 v[92:95], v[16:17], v[138:139], 0
    v_mfma_f32_16x16x16_bf16 v[96:99], v[16:17], v[140:141], 0
    v_mfma_f32_16x16x16_bf16 v[100:103], v[16:17], v[142:143], 0
    s_nop 0
L_j3:
    v_cvt_pk_bf16_f32 v72, 0, v72
    v_cvt_pk_bf16_f32 v73, 0, v73
    v_cvt_pk_bf16_f32 v76, 0, v76
    v_cvt_pk_bf16_f32 v77, 0, v77
    v_cvt_pk_bf16_f32 v80, 0, v80
    v_cvt_pk_bf16_f32 v81, 0, v81
    v_cvt_pk_bf16_f32 v84, 0, v84
    v_cvt_pk_bf16_f32 v85, 0, v85
    v_cvt_pk_bf16_f32 v88, 0, v88
    v_cvt_pk_bf16_f32 v89, 0, v89
    v_cvt_pk_bf16_f32 v92, 0, v92
    v_cvt_pk_bf16_f32 v93, 0, v93
    v_cvt_pk_bf16_f32 v96, 0, v96
    v_cvt_pk_bf16_f32 v97, 0, v97
    v_cvt_pk_bf16_f32 v100, 0, v100
    v_cvt_pk_bf16_f32 v101, 0, v101
    v_pk_mul_f32 v[72:73], v[72:73], v[152:153]
    v_pk_mul_f32 v[76:77], v[76:77], v[152:153]
    v_pk_mul_f32 v[80:81], v[80:81], v[152:153]
    v_pk_mul_f32 v[84:85], v[84:85], v[152:153]
    v_pk_mul_f32 v[88:89], v[88:89], v[152:153]
    v_pk_mul_f32 v[92:93], v[92:93], v[152:153]
    v_pk_mul_f32 v[96:97], v[96:97], v[152:153]
    v_pk_mul_f32 v[100:101], v[100:101], v[152:153]
    v_cvt_pk_bf16_f32 v104, v72, v76
    v_cvt_pk_bf16_f32 v105, v80, v84
    v_cvt_pk_bf16_f32 v106, v88, v92
    v_cvt_pk_bf16_f32 v107, v96, v100
    buffer_store_dwordx4 v[104:107], v14, s[12:15], s29 offen offset:0 nt
    v_cvt_pk_bf16_f32 v108, v73, v77
    v_cvt_pk_bf16_f32 v109, v81, v85
    v_cvt_pk_bf16_f32 v110, v89, v93
    v_cvt_pk_bf16_f32 v111, v97, v101
    buffer_store_dwordx4 v[108:111], v14, s[12:15], s29 offen offset:256 nt
    v_cvt_pk_bf16_f32 v74, 0, v74
    v_cvt_pk_bf16_f32 v75, 0, v75
    v_cvt_pk_bf16_f32 v78, 0, v78
    v_cvt_pk_bf16_f32 v79, 0, v79
    v_cvt_pk_bf16_f32 v82, 0, v82
    v_cvt_pk_bf16_f32 v83, 0, v83
    v_cvt_pk_bf16_f32 v86, 0, v86
    v_cvt_pk_bf16_f32 v87, 0, v87
    v_cvt_pk_bf16_f32 v90, 0, v90
    v_cvt_pk_bf16_f32 v91, 0, v91
    v_cvt_pk_bf16_f32 v94, 0, v94
    v_cvt_pk_bf16_f32 v95, 0, v95
    v_cvt_pk_bf16_f32 v98, 0, v98
    v_cvt_pk_bf16_f32 v99, 0, v99
    v_cvt_pk_bf16_f32 v102, 0, v102
    v_cvt_pk_bf16_f32 v103, 0, v103
    v_pk_mul_f32 v[74:75], v[74:75], v[154:155]
    v_pk_mul_f32 v[78:79], v[78:79], v[154:155]
    v_pk_mul_f32 v[82:83], v[82:83], v[154:155]
    v_pk_mul_f32 v[86:87], v[86:87], v[154:155]
    v_pk_mul_f32 v[90:91], v[90:91], v[154:155]
    v_pk_mul_f32 v[94:95], v[94:95], v[154:155]
    v_pk_mul_f32 v[98:99], v[98:99], v[154:155]
    v_pk_mul_f32 v[102:103], v[102:103], v[154:155]
    v_cvt_pk_bf16_f32 v112, v74, v78
    v_cvt_pk_bf16_f32 v113, v82, v86
    v_cvt_pk_bf16_f32 v114, v90, v94
    v_cvt_pk_bf16_f32 v115, v98, v102
    buffer_store_dwordx4 v[112:115], v14, s[12:15], s29 offen offset:512 nt
    v_cvt_pk_bf16_f32 v116, v75, v79
    v_cvt_pk_bf16_f32 v117, v83, v87
    v_cvt_pk_bf16_f32 v118, v91, v95
    v_cvt_pk_bf16_f32 v119, v99, v103
    buffer_store_dwordx4 v[116:119], v14, s[12:15], s29 offen offset:768 nt
L_fin:
L_end:
    s_endpgm
L_phik:
    s_waitcnt lgkmcnt(3)
    v_lshlrev_b32 v104, 16, v72
    v_and_b32 v105, 0xffff0000, v72
    v_lshlrev_b32 v106, 16, v73
    v_and_b32 v107, 0xffff0000, v73
    v_lshlrev_b32 v108, 16, v74
    v_and_b32 v109, 0xffff0000, v74
    v_lshlrev_b32 v110, 16, v75
    v_and_b32 v111, 0xffff0000, v75
    v_pk_mul_f32 v[104:105], v[104:105], s[34:35]
    v_pk_mul_f32 v[106:107], v[106:107], s[34:35]
    v_pk_mul_f32 v[108:109], v[108:109], s[34:35]
    v_pk_mul_f32 v[110:111], v[110:111], s[34:35]
    v_cvt_pk_bf16_f32 v72, v104, v105
    v_cvt_pk_bf16_f32 v73, v106, v107
    v_cvt_pk_bf16_f32 v74, v108, v109
    v_cvt_pk_bf16_f32 v75, v110, v111
    s_waitcnt lgkmcnt(2)
    v_lshlrev_b32 v104, 16, v76
    v_and_b32 v105, 0xffff0000, v76
    v_lshlrev_b32 v106, 16, v77
    v_and_b32 v107, 0xffff0000, v77
    v_lshlrev_b32 v108, 16, v78
    v_and_b32 v109, 0xffff0000, v78
    v_lshlrev_b32 v110, 16, v79
    v_and_b32 v111, 0xffff0000, v79
    v_pk_mul_f32 v[104:105], v[104:105], s[34:35]
    v_pk_mul_f32 v[106:107], v[106:107], s[34:35]
    v_pk_mul_f32 v[108:109], v[108:109], s[34:35]
    v_pk_mul_f32 v[110:111], v[110:111], s[34:35]
    v_cvt_pk_bf16_f32 v76, v104, v105
    v_cvt_pk_bf16_f32 v77, v106, v107
    v_cvt_pk_bf16_f32 v78, v108, v109
    v_cvt_pk_bf16_f32 v79, v110, v111
    v_mfma_f32_16x16x32_bf16 v[124:127], v[72:75], v[72:75], 0
    v_mfma_f32_16x16x32_bf16 v[120:123], v[72:75], v[24:27], 0
    s_waitcnt lgkmcnt(1)
    v_lshlrev_b32 v104, 16, v80
    v_and_b32 v105, 0xffff0000, v80
    v_lshlrev_b32 v106, 16, v81
    v_and_b32 v107, 0xffff0000, v81
    v_lshlrev_b32 v108, 16, v82
    v_and_b32 v109, 0xffff0000, v82
    v_lshlrev_b32 v110, 16, v83
    v_and_b32 v111, 0xffff0000, v83
    v_pk_mul_f32 v[104:105], v[104:105], s[34:35]
    v_pk_mul_f32 v[106:107], v[106:107], s[34:35]
    v_pk_mul_f32 v[108:109], v[108:109], s[34:35]
    v_pk_mul_f32 v[110:111], v[110:111], s[34:35]
    v_cvt_pk_bf16_f32 v80, v104, v105
    v_cvt_pk_bf16_f32 v81, v106, v107
    v_cvt_pk_bf16_f32 v82, v108, v109
    v_cvt_pk_bf16_f32 v83, v110, v111
    v_mfma_f32_16x16x32_bf16 v[124:127], v[76:79], v[76:79], v[124:127]
    v_mfma_f32_16x16x32_bf16 v[120:123], v[76:79], v[28:31], v[120:123]
    s_waitcnt lgkmcnt(0)
    v_lshlrev_b32 v104, 16, v84
    v_and_b32 v105, 0xffff0000, v84
    v_lshlrev_b32 v106, 16, v85
    v_and_b32 v107, 0xffff0000, v85
    v_lshlrev_b32 v108, 16, v86
    v_and_b32 v109, 0xffff0000, v86
    v_lshlrev_b32 v110, 16, v87
    v_and_b32 v111, 0xffff0000, v87
    v_pk_mul_f32 v[104:105], v[104:105], s[34:35]
    v_pk_mul_f32 v[106:107], v[106:107], s[34:35]
    v_pk_mul_f32 v[108:109], v[108:109], s[34:35]
    v_pk_mul_f32 v[110:111], v[110:111], s[34:35]
    v_cvt_pk_bf16_f32 v84, v104, v105
    v_cvt_pk_bf16_f32 v85, v106, v107
    v_cvt_pk_bf16_f32 v86, v108, v109
    v_cvt_pk_bf16_f32 v87, v110, v111
    v_mfma_f32_16x16x32_bf16 v[124:127], v[80:83], v[80:83], v[124:127]
    v_mfma_f32_16x16x32_bf16 v[120:123], v[80:83], v[32:35], v[120:123]
    v_mfma_f32_16x16x32_bf16 v[124:127], v[84:87], v[84:87], v[124:127]
    v_mfma_f32_16x16x32_bf16 v[120:123], v[84:87], v[36:39], v[120:123]
    s_nop 6
    v_cndmask_b32 v104, 0, v124, s[40:41]
    v_cndmask_b32 v104, v104, v125, s[42:43]
    v_cndmask_b32 v104, v104, v126, s[44:45]
    v_cndmask_b32 v104, v104, v127, s[46:47]
    v_cvt_pk_bf16_f32 v22, v104, v23
    v_cvt_pk_bf16_f32 v108, 0, v120
    v_cvt_pk_bf16_f32 v109, 0, v121
    v_cvt_pk_bf16_f32 v110, 0, v122
    v_cvt_pk_bf16_f32 v111, 0, v123
    s_nop 1
    v_mfma_f32_16x16x16_bf16 v[120:123], v[22:23], v[20:21], v[108:111]
    s_nop 7
    v_cvt_pk_bf16_f32 v112, 0, v120
    v_cvt_pk_bf16_f32 v113, 0, v121
    v_cvt_pk_bf16_f32 v114, 0, v122
    v_cvt_pk_bf16_f32 v115, 0, v123
    v_pk_mul_f32 v[112:113], v[112:113], s[36:37]
    v_pk_mul_f32 v[114:115], v[114:115], s[36:37]
    v_exp_f32 v112, v112
    v_exp_f32 v113, v113
    v_exp_f32 v114, v114
    v_exp_f32 v115, v115
    s_nop 0
    v_cvt_pk_bf16_f32 v116, 0, v112
    v_cvt_pk_bf16_f32 v117, 0, v113
    v_cvt_pk_bf16_f32 v118, 0, v114
    v_cvt_pk_bf16_f32 v119, 0, v115
    v_pk_fma_f32 v[116:117], v[116:117], s[38:39], v[18:19]
    v_pk_fma_f32 v[118:119], v[118:119], s[38:39], v[18:19]
    v_cvt_pk_bf16_f32 v16, v116, v117
    v_cvt_pk_bf16_f32 v17, v118, v119
    s_setpc_b64 s[58:59]
L_phiq:
    s_waitcnt lgkmcnt(3)
    v_lshlrev_b32 v104, 16, v72
    v_and_b32 v105, 0xffff0000, v72
    v_lshlrev_b32 v106, 16, v73
    v_and_b32 v107, 0xffff0000, v73
    v_lshlrev_b32 v108, 16, v74
    v_and_b32 v109, 0xffff0000, v74
    v_lshlrev_b32 v110, 16, v75
    v_and_b32 v111, 0xffff0000, v75
    v_pk_mul_f32 v[104:105], v[104:105], s[34:35]
    v_pk_mul_f32 v[106:107], v[106:107], s[34:35]
    v_pk_mul_f32 v[108:109], v[108:109], s[34:35]
    v_pk_mul_f32 v[110:111], v[110:111], s[34:35]
    v_cvt_pk_bf16_f32 v72, v104, v105
    v_cvt_pk_bf16_f32 v73, v106, v107
    v_cvt_pk_bf16_f32 v74, v108, v109
    v_cvt_pk_bf16_f32 v75, v110, v111
    s_waitcnt lgkmcnt(2)
    v_lshlrev_b32 v104, 16, v76
    v_and_b32 v105, 0xffff0000, v76
    v_lshlrev_b32 v106, 16, v77
    v_and_b32 v107, 0xffff0000, v77
    v_lshlrev_b32 v108, 16, v78
    v_and_b32 v109, 0xffff0000, v78
    v_lshlrev_b32 v110, 16, v79
    v_and_b32 v111, 0xffff0000, v79
    v_pk_mul_f32 v[104:105], v[104:105], s[34:35]
    v_pk_mul_f32 v[106:107], v[106:107], s[34:35]
    v_pk_mul_f32 v[108:109], v[108:109], s[34:35]
    v_pk_mul_f32 v[110:111], v[110:111], s[34:35]
    v_cvt_pk_bf16_f32 v76, v104, v105
    v_cvt_pk_bf16_f32 v77, v106, v107
    v_cvt_pk_bf16_f32 v78, v108, v109
    v_cvt_pk_bf16_f32 v79, v110, v111
    v_mfma_f32_16x16x32_bf16 v[124:127], v[72:75], v[72:75], 0
    v_mfma_f32_16x16x32_bf16 v[120:123], v[24:27], v[72:75], 0
    s_waitcnt lgkmcnt(1)
    v_lshlrev_b32 v104, 16, v80
    v_and_b32 v105, 0xffff0000, v80
    v_lshlrev_b32 v106, 16, v81
    v_and_b32 v107, 0xffff0000, v81
    v_lshlrev_b32 v108, 16, v82
    v_and_b32 v109, 0xffff0000, v82
    v_lshlrev_b32 v110, 16, v83
    v_and_b32 v111, 0xffff0000, v83
    v_pk_mul_f32 v[104:105], v[104:105], s[34:35]
    v_pk_mul_f32 v[106:107], v[106:107], s[34:35]
    v_pk_mul_f32 v[108:109], v[108:109], s[34:35]
    v_pk_mul_f32 v[110:111], v[110:111], s[34:35]
    v_cvt_pk_bf16_f32 v80, v104, v105
    v_cvt_pk_bf16_f32 v81, v106, v107
    v_cvt_pk_bf16_f32 v82, v108, v109
    v_cvt_pk_bf16_f32 v83, v110, v111
    v_mfma_f32_16x16x32_bf16 v[124:127], v[76:79], v[76:79], v[124:127]
    v_mfma_f32_16x16x32_bf16 v[120:123], v[28:31], v[76:79], v[120:123]
    s_waitcnt lgkmcnt(0)
    v_lshlrev_b32 v104, 16, v84
    v_and_b32 v105, 0xffff0000, v84
    v_lshlrev_b32 v106, 16, v85
    v_and_b32 v107, 0xffff0000, v85
    v_lshlrev_b32 v108, 16, v86
    v_and_b32 v109, 0xffff0000, v86
    v_lshlrev_b32 v110, 16, v87
    v_and_b32 v111, 0xffff0000, v87
    v_pk_mul_f32 v[104:105], v[104:105], s[34:35]
    v_pk_mul_f32 v[106:107], v[106:107], s[34:35]
    v_pk_mul_f32 v[108:109], v[108:109], s[34:35]
    v_pk_mul_f32 v[110:111], v[110:111], s[34:35]
    v_cvt_pk_bf16_f32 v84, v104, v105
    v_cvt_pk_bf16_f32 v85, v106, v107
    v_cvt_pk_bf16_f32 v86, v108, v109
    v_cvt_pk_bf16_f32 v87, v110, v111
    v_mfma_f32_16x16x32_bf16 v[124:127], v[80:83], v[80:83], v[124:127]
    v_mfma_f32_16x16x32_bf16 v[120:123], v[32:35], v[80:83], v[120:123]
    v_mfma_f32_16x16x32_bf16 v[124:127], v[84:87], v[84:87], v[124:127]
    v_mfma_f32_16x16x32_bf16 v[120:123], v[36:39], v[84:87], v[120:123]
    s_nop 6
    v_cndmask_b32 v104, 0, v124, s[40:41]
    v_cndmask_b32 v104, v104, v125, s[42:43]
    v_cndmask_b32 v104, v104, v126, s[44:45]
    v_cndmask_b32 v104, v104, v127, s[46:47]
    v_cvt_pk_bf16_f32 v22, v104, v23
    v_cvt_pk_bf16_f32 v108, 0, v120
    v_cvt_pk_bf16_f32 v109, 0, v121
    v_cvt_pk_bf16_f32 v110, 0, v122
    v_cvt_pk_bf16_f32 v111, 0, v123
    s_nop 1
    v_mfma_f32_16x16x16_bf16 v[120:123], v[20:21], v[22:23], v[108:111]
    s_nop 7
    v_cvt_pk_bf16_f32 v112, 0, v120
    v_cvt_pk_bf16_f32 v113, 0, v121
    v_cvt_pk_bf16_f32 v114, 0, v122
    v_cvt_pk_bf16_f32 v115, 0, v123
    v_pk_mul_f32 v[112:113], v[112:113], s[36:37]
    v_pk_mul_f32 v[114:115], v[114:115], s[36:37]
    v_exp_f32 v112, v112
    v_exp_f32 v113, v113
    v_exp_f32 v114, v114
    v_exp_f32 v115, v115
    s_nop 0
    v_cvt_pk_bf16_f32 v116, 0, v112
    v_cvt_pk_bf16_f32 v117, 0, v113
    v_cvt_pk_bf16_f32 v118, 0, v114
    v_cvt_pk_bf16_f32 v119, 0, v115
    v_pk_fma_f32 v[116:117], v[116:117], s[38:39], v[18:19]
    v_pk_fma_f32 v[118:119], v[118:119], s[38:39], v[18:19]
    v_cvt_pk_bf16_f32 v16, v116, v117
    v_cvt_pk_bf16_f32 v17, v118, v119
    s_setpc_b64 s[58:59]
L_regather:
    s_cbranch_scc1 L_gok
    buffer_load_dwordx4 v[44:47], v5, s[16:19], s64 offen sc1
    buffer_load_dwordx4 v[48:51], v5, s[16:19], s65 offen sc1
    buffer_load_dwordx4 v[52:55], v5, s[16:19], s66 offen sc1
    buffer_load_dwordx4 v[56:59], v5, s[16:19], s67 offen sc1
    buffer_load_dwordx4 v[60:63], v5, s[16:19], s68 offen sc1
    buffer_load_dwordx4 v[64:67], v5, s[16:19], s69 offen sc1
    buffer_load_dwordx4 v[68:71], v5, s[16:19], s70 offen sc1
    buffer_load_dword v88, v157, s[16:19], s50 offen sc1
    s_branch L_gsum
L_zbad:
    s_sub_u32 s55, s55, 1
    s_cbranch_scc1 L_zgive
    buffer_load_dwordx4 v[92:95], v9, s[16:19], s26 offen sc1
    buffer_load_dword v91, v165, s[16:19], s26 offen offset:64 sc1
    s_waitcnt vmcnt(0)
    s_branch L_zchk
L_zgive:
    s_mov_b32 s55, 0
    s_branch L_zok
L_codeend:
.section .rodata,"a"
.p2align 6
.amdhsa_kernel standalone__linear_kernel_rfa__prompt_kernel
  .amdhsa_next_free_vgpr 168
  .amdhsa_next_free_sgpr 72
  .amdhsa_accum_offset 168
  .amdhsa_group_segment_fixed_size 0
  .amdhsa_kernarg_size 56
  .amdhsa_user_sgpr_count 2
  .amdhsa_user_sgpr_kernarg_segment_ptr 1
  .amdhsa_system_sgpr_workgroup_id_x 1
  .amdhsa_float_denorm_mode_32 3
  .amdhsa_float_denorm_mode_16_64 3
.end_amdhsa_kernel
```
